```python
import torch

def _softmax(x, axis=-1):
    return torch.softmax(x, dim=axis)
def _gelu(x):
    return torch.nn.functional.gelu(x, approximate="tanh")
def _silu(x):
    return torch.nn.functional.silu(x)
def _sigmoid(x):
    return torch.sigmoid(x)
def _layernorm(x, axis=-1, eps=1e-5):
    m = x.mean(dim=axis, keepdim=True)
    v = x.var(dim=axis, keepdim=True, unbiased=False)
    return (x - m) / torch.sqrt(v + eps)
def _scatter_add(tgt, idx, src, axis=0):
    return tgt.clone().index_add_(axis, idx, src)
def _segment_sum(src, seg, n):
    out = torch.zeros((n,) + src.shape[1:], dtype=src.dtype)
    return out.index_add_(0, seg, src)
def _pad(x, pw):
    flat = tuple(v for pair in reversed(pw) for v in pair)
    return torch.nn.functional.pad(x, flat)

kernel_name = 'gated_mix__sliding_block_cached__glu_gated_reglu__decode'

def setup_inputs():

    _w = (lambda a: (lambda t: t.to(torch.bfloat16) if t.is_floating_point() else t)(torch.as_tensor(a)))
    def _A_setup():
        B, Sq, D = 1, 1, 640
        Hq, Hkv, Sk, Dh = 32, 32, 32768, 192
        assert Hq % Hkv == 0, (Hq, Hkv)
        return {
            "x": _w((lambda *s: torch.randn(*s, dtype=torch.bfloat16) * 0.05)(B, Sq, D)),
            "k_cache": _w((lambda *s: torch.randn(*s, dtype=torch.bfloat16) * 6.4)(B, Hkv, Sk, Dh)),
            "v_cache": _w((lambda *s: torch.randn(*s, dtype=torch.bfloat16) * 0.05)(B, Hkv, Sk, Dh)),
            "wq": _w((lambda *s: torch.randn(*s, dtype=torch.bfloat16) * 6.4)(D, Hq * Dh) * (D ** -0.5)),
            "wo": _w((lambda *s: torch.randn(*s, dtype=torch.bfloat16) * 0.05)(Hq * Dh, D) * ((Hq * Dh) ** -0.5)),
        }
    _A_in = _A_setup()

    def _B_setup():
        B, S, D, F = 1, 1, 640, 1536
        return {
            "x": _w((lambda *s: torch.randn(*s, dtype=torch.bfloat16) * 0.05)(B, S, D)),
            "W_gate": _w((lambda *s: torch.randn(*s, dtype=torch.bfloat16) * 0.4)(D, F) * (2.0 / D) ** 0.5),
            "W_up": _w((lambda *s: torch.randn(*s, dtype=torch.bfloat16) * 0.4)(D, F) * (2.0 / D) ** 0.5),
            "W_down": _w((lambda *s: torch.randn(*s, dtype=torch.bfloat16) * 0.4)(F, D) * (1.0 / F) ** 0.5),
        }
    _B_in = _B_setup()

    return {
        "A_x": _A_in["x"],
        "A_k_cache": _A_in["k_cache"],
        "A_v_cache": _A_in["v_cache"],
        "A_wq": _A_in["wq"],
        "A_wo": _A_in["wo"],
        "B_x": _B_in["x"],
        "B_W_gate": _B_in["W_gate"],
        "B_W_up": _B_in["W_up"],
        "B_W_down": _B_in["W_down"],
        "gate_w": _w((lambda *s: torch.randn(*s, dtype=torch.bfloat16) * 0.1)(640) * 16.0),
    }

def reference(A_x, A_k_cache, A_v_cache, A_wq, A_wo, B_x, B_W_gate, B_W_up, B_W_down, gate_w):
    def _A_ref(x, k_cache, v_cache, wq, wo):
        B, Sq, D = x.shape
        Hq, Dh = 32, 192
        Hkv, Sk = k_cache.shape[1], k_cache.shape[2]
        W = min(4096, max(256, Sk // 4))
        rep = Hq // Hkv
        q = (lambda x, *d: x.permute(*d))((x @ wq).reshape(B, Sq, Hq, Dh), 0, 2, 1, 3)
        k = (lambda x, n, axis: torch.repeat_interleave(x, n, dim=axis))(k_cache[:, :, Sk - W:, :], rep, axis=1)
        v = (lambda x, n, axis: torch.repeat_interleave(x, n, dim=axis))(v_cache[:, :, Sk - W:, :], rep, axis=1)
        scores = torch.einsum("bhqd,bhkd->bhqk", q, k) * (Dh ** -0.5)
        p = _softmax(scores, axis=-1)
        o = torch.einsum("bhqk,bhkd->bhqd", p, v)
        return (lambda x, *d: x.permute(*d))(o, 0, 2, 1, 3).reshape(B, Sq, Hq * Dh) @ wo

    def _B_ref(x, W_gate, W_up, W_down):
        gate = torch.einsum("bsd,df->bsf", x, W_gate)
        up = torch.einsum("bsd,df->bsf", x, W_up)
        gate = gate * (lambda x, dt: x.to(dt))(gate > 0, gate.dtype)
        h = gate * up
        return torch.einsum("bsf,fd->bsd", h, W_down)

    x = A_x
    g = _sigmoid((x * gate_w).sum(-1, keepdims=True))
    a = _A_ref(x, A_k_cache, A_v_cache, A_wq, A_wo)
    b = _B_ref(x, B_W_gate, B_W_up, B_W_down)
    return g * a + (1 - g) * b
```

```asm
; @launch grid=(256,1,1) block=(512,1,1) lds=65536
.amdgcn_target "amdgcn-amd-amdhsa--gfx950"
.text
.globl gated_mix__sliding_block_cached__glu_gated_reglu__decode_kernel
.p2align 8
.type gated_mix__sliding_block_cached__glu_gated_reglu__decode_kernel,@function
gated_mix__sliding_block_cached__glu_gated_reglu__decode_kernel:
    s_cmp_ge_u32 s2, 256
    s_cbranch_scc1 K1_END
    s_load_dwordx16 s[8:23], s[0:1], 0
    s_load_dwordx8 s[24:31], s[0:1], 64
    s_load_dwordx2 s[32:33], s[0:1], 96
    v_and_b32 v1, 63, v0
    v_bfe_u32 v2, v0, 4, 2
    v_and_b32 v3, 15, v0
    v_lshrrev_b32 v8, 6, v0
    s_nop 0
    v_readfirstlane_b32 s34, v8
    s_and_b32 s35, s2, 7
    s_lshr_b32 s36, s2, 3
    s_and_b32 s37, s36, 3
    s_lshl_b32 s39, s35, 2
    s_add_u32 s37, s37, s39
    s_lshr_b32 s38, s36, 2
    s_lshl_b32 s85, s37, 3
    s_add_u32 s85, s85, s38
    s_mul_i32 s84, s37, 5
    s_mul_i32 s39, s38, 3
    s_add_u32 s84, s84, s39
    s_and_b32 s84, s84, 7
    s_mov_b32 s3, 0x40003
    s_getreg_b32 s76, hwreg(HW_REG_XCC_ID)
    s_and_b32 s76, s76, 15
    s_mov_b32 s78, 0xFF00FF00
    s_mov_b32 s79, 0xFF00FF00
    s_mov_b32 s80, 0x00FF00FF
    s_mov_b32 s81, 0xFF00FF00
    s_mov_b32 s83, 0x3dd53b95
    v_and_b32 v8, 1, v3
    v_lshlrev_b32 v8, 4, v8
    v_mov_b32 v9, 0xffff
    v_lshlrev_b32 v9, v8, v9
    v_bfe_u32 v10, v3, 1, 2
    v_cmp_eq_u32 vcc, 0, v10
    s_nop 1
    v_cndmask_b32 v4, 0, v9, vcc
    v_cmp_eq_u32 vcc, 1, v10
    s_nop 1
    v_cndmask_b32 v5, 0, v9, vcc
    v_cmp_eq_u32 vcc, 2, v10
    s_nop 1
    v_cndmask_b32 v6, 0, v9, vcc
    v_cmp_eq_u32 vcc, 3, v10
    s_nop 1
    v_cndmask_b32 v7, 0, v9, vcc
    v_lshrrev_b32 v8, 3, v3
    v_lshl_add_u32 v9, v8, 2, v2
    v_and_b32 v10, 7, v3
    v_mul_u32_u24 v32, 12288, v2
    v_lshl_add_u32 v32, v3, 4, v32
    v_add_u32 v33, 49152, v32
    v_mul_u32_u24 v34, 12288, v9
    v_lshl_add_u32 v34, v10, 4, v34
    v_add_u32 v34, 256, v34
    v_mul_u32_u24 v35, 3072, v9
    v_lshl_add_u32 v35, v10, 4, v35
    v_mov_b32 v11, 0x40000000
    v_cmp_gt_u32 vcc, 6, v10
    s_nop 1
    v_cndmask_b32 v35, v11, v35, vcc
    v_lshlrev_b32 v36, 1, v9
    v_lshlrev_b32 v37, 2, v0
    v_and_b32 v252, 3, v3
    v_add_u32 v252, s84, v252
    v_and_b32 v252, 7, v252
    v_lshlrev_b32 v252, 3, v252
    v_bfe_u32 v11, v3, 2, 1
    v_add_u32 v252, v252, v11
    v_mul_u32_u24 v252, 384, v252
    v_lshl_add_u32 v252, v2, 4, v252
    v_lshlrev_b32 v11, 6, v8
    v_sub_u32 v253, v252, v11
    v_add_u32 v253, 64, v253
    v_add_u32 v252, v252, v11
    v_and_b32 v254, 3, v3
    v_add_u32 v254, s84, v254
    v_add_u32 v254, 4, v254
    v_and_b32 v254, 7, v254
    v_lshlrev_b32 v254, 3, v254
    v_bfe_u32 v11, v3, 2, 1
    v_add_u32 v254, v254, v11
    v_mul_u32_u24 v254, 384, v254
    v_lshl_add_u32 v254, v2, 4, v254
    v_lshlrev_b32 v11, 6, v8
    v_sub_u32 v255, v254, v11
    v_add_u32 v255, 64, v255
    v_add_u32 v254, v254, v11
    s_waitcnt lgkmcnt(0)
    s_load_dwordx2 s[4:5], s[32:33], 0
    s_mul_i32 s39, s37, 12582912
    s_mul_i32 s82, s38, 24576
    s_add_u32 s39, s39, s82
    s_mul_i32 s82, s34, 196608
    s_add_u32 s39, s39, s82
    s_add_u32 s39, s39, 11010048
    s_add_u32 s40, s10, s39
    s_addc_u32 s41, s11, 0
    s_and_b32 s41, s41, 0xffff
    s_mov_b32 s42, 24576
    s_mov_b32 s43, 0x00020000
    s_add_u32 s44, s12, s39
    s_addc_u32 s45, s13, 0
    s_and_b32 s45, s45, 0xffff
    s_mov_b32 s46, 24576
    s_mov_b32 s47, 0x00020000
    s_mul_i32 s88, s38, 80
    s_lshl_b32 s82, s34, 3
    s_add_u32 s88, s88, s82
    s_mul_i32 s39, s88, 12288
    s_mul_i32 s82, s37, 384
    s_add_u32 s39, s39, s82
    s_add_u32 s48, s14, s39
    s_addc_u32 s49, s15, 0
    s_and_b32 s49, s49, 0xffff
    s_mov_b32 s50, 884736
    s_mov_b32 s51, 0x00020000
    s_mul_i32 s39, s88, 3072
    s_mul_i32 s82, s37, 96
    s_add_u32 s39, s39, s82
    s_add_u32 s56, s20, s39
    s_addc_u32 s57, s21, 0
    s_and_b32 s57, s57, 0xffff
    s_mov_b32 s58, 221184
    s_mov_b32 s59, 0x00020000
    s_add_u32 s60, s22, s39
    s_addc_u32 s61, s23, 0
    s_and_b32 s61, s61, 0xffff
    s_mov_b32 s62, 221184
    s_mov_b32 s63, 0x00020000
    s_lshl_b32 s89, s88, 1
    s_mov_b32 s39, 0
    s_add_u32 s68, s8, s39
    s_addc_u32 s69, s9, 0
    s_and_b32 s69, s69, 0xffff
    s_mov_b32 s70, 1280
    s_mov_b32 s71, 0x00020000
    s_add_u32 s72, s32, s39
    s_addc_u32 s73, s33, 0
    s_and_b32 s73, s73, 0xffff
    s_mov_b32 s74, 4194304
    s_mov_b32 s75, 0x00020000
    s_cmp_lt_u32 s34, 2
    s_cselect_b32 s90, 786432, 0x40000000
    s_cselect_b32 s91, 196608, 0x40000000
    buffer_load_ushort v12, v36, s[68:71], s89 offen
    buffer_load_ushort v13, v36, s[68:71], s89 offen offset:128
    buffer_load_dwordx4 v[136:139], v32, s[48:51], 0 offen
    buffer_load_dwordx4 v[140:143], v33, s[48:51], 0 offen
    buffer_load_dwordx4 v[144:147], v34, s[48:51], 0 offen
    buffer_load_dwordx4 v[148:151], v35, s[56:59], 0 offen
    buffer_load_dwordx4 v[152:155], v35, s[60:63], 0 offen
    v_add_u32 v32, s90, v32
    v_add_u32 v33, s90, v33
    v_add_u32 v34, s90, v34
    v_add_u32 v35, s91, v35
    buffer_load_dwordx4 v[156:159], v32, s[48:51], 0 offen
    buffer_load_dwordx4 v[160:163], v33, s[48:51], 0 offen
    buffer_load_dwordx4 v[164:167], v34, s[48:51], 0 offen
    buffer_load_dwordx4 v[168:171], v35, s[56:59], 0 offen
    buffer_load_dwordx4 v[172:175], v35, s[60:63], 0 offen
    s_mov_b32 s52, s26
    s_and_b32 s53, s27, 0xffff
    s_mov_b32 s54, 1280
    s_mov_b32 s55, 0x00020000
    buffer_load_dword v14, v37, s[68:71], 0 offen
    buffer_load_dword v15, v37, s[52:55], 0 offen
    s_mul_i32 s39, s37, 245760
    s_mul_i32 s82, s38, 160
    s_add_u32 s39, s39, s82
    s_add_u32 s52, s16, s39
    s_addc_u32 s53, s17, 0
    s_and_b32 s53, s53, 0xffff
    s_mov_b32 s54, 244640
    s_mov_b32 s55, 0x00020000
    s_mul_i32 s39, s37, 61440
    s_add_u32 s39, s39, s82
    s_add_u32 s64, s24, s39
    s_addc_u32 s65, s25, 0
    s_and_b32 s65, s65, 0xffff
    s_mov_b32 s66, 60320
    s_mov_b32 s67, 0x00020000
    s_mov_b32 s82, 12288
    buffer_load_dwordx4 v[40:43], v252, s[40:43], 0 offen offset:0 nt
    buffer_load_dwordx4 v[44:47], v252, s[40:43], 0 offen offset:128 nt
    buffer_load_dwordx4 v[48:51], v252, s[40:43], 0 offen offset:256 nt
    buffer_load_dwordx4 v[52:55], v253, s[40:43], 0 offen offset:768 nt
    buffer_load_dwordx4 v[56:59], v253, s[40:43], 0 offen offset:896 nt
    buffer_load_dwordx4 v[60:63], v253, s[40:43], 0 offen offset:1024 nt
    buffer_load_dwordx4 v[64:67], v252, s[40:43], 0 offen offset:2304 nt
    buffer_load_dwordx4 v[68:71], v252, s[40:43], 0 offen offset:2432 nt
    s_waitcnt vmcnt(20)
    v_lshl_or_b32 v12, v12, 16, v12
    v_lshl_or_b32 v13, v13, 16, v13
    v_and_b32 v232, v12, v4
    v_and_b32 v233, v12, v5
    v_and_b32 v234, v12, v6
    v_and_b32 v235, v12, v7
    v_and_b32 v236, v13, v4
    v_and_b32 v237, v13, v5
    v_and_b32 v238, v13, v6
    v_and_b32 v239, v13, v7
    s_waitcnt vmcnt(15)
    v_mfma_f32_16x16x32_bf16 v[16:19], v[136:139], v[232:235], 0
    v_mfma_f32_16x16x32_bf16 v[20:23], v[140:143], v[232:235], 0
    v_mfma_f32_16x16x32_bf16 v[24:27], v[144:147], v[232:235], 0
    v_mfma_f32_16x16x32_bf16 v[28:31], v[148:151], v[232:235], 0
    v_mfma_f32_16x16x32_bf16 v[32:35], v[152:155], v[232:235], 0
    s_waitcnt vmcnt(10)
    v_mfma_f32_16x16x32_bf16 v[16:19], v[156:159], v[236:239], v[16:19]
    v_mfma_f32_16x16x32_bf16 v[20:23], v[160:163], v[236:239], v[20:23]
    v_mfma_f32_16x16x32_bf16 v[24:27], v[164:167], v[236:239], v[24:27]
    v_mfma_f32_16x16x32_bf16 v[28:31], v[168:171], v[236:239], v[28:31]
    v_mfma_f32_16x16x32_bf16 v[32:35], v[172:175], v[236:239], v[32:35]
    s_waitcnt vmcnt(8)
    v_lshlrev_b32 v12, 16, v14
    v_and_b32 v14, 0xffff0000, v14
    v_lshlrev_b32 v13, 16, v15
    v_and_b32 v15, 0xffff0000, v15
    v_mul_f32 v12, v12, v13
    v_fmac_f32 v12, v14, v15
    s_nop 1
    v_add_f32_dpp v12, v12, v12 row_shr:1 row_mask:0xf bank_mask:0xf bound_ctrl:0
    s_nop 1
    v_add_f32_dpp v12, v12, v12 row_shr:2 row_mask:0xf bank_mask:0xf bound_ctrl:0
    s_nop 1
    v_add_f32_dpp v12, v12, v12 row_shr:4 row_mask:0xf bank_mask:0xf bound_ctrl:0
    s_nop 1
    v_add_f32_dpp v12, v12, v12 row_shr:8 row_mask:0xf bank_mask:0xf bound_ctrl:0
    s_nop 1
    v_add_f32_dpp v12, v12, v12 row_bcast:15 row_mask:0xa bank_mask:0xf
    s_nop 1
    v_add_f32_dpp v12, v12, v12 row_bcast:31 row_mask:0xc bank_mask:0xf
    v_lshrrev_b32 v10, 3, v3
    s_lshl_b32 s39, s34, 1
    v_add_u32 v10, s39, v10
    v_mul_u32_u24 v8, 1312, v10
    v_and_b32 v10, 7, v3
    v_lshl_add_u32 v8, v10, 2, v8
    v_and_b32 v10, 1, v2
    v_lshl_add_u32 v9, v10, 7, v8
    v_lshl_add_u32 v8, v2, 7, v8
    s_lshl_b32 s39, s34, 2
    v_mov_b32 v10, s39
    s_mov_b32 exec_lo, 0
    s_mov_b32 exec_hi, 0x80000000
    ds_write_b32 v10, v12 offset:43840
    s_mov_b64 exec, -1
    s_nop 3
    v_cndmask_b32 v16, v16, v20, s[78:79]
    v_cndmask_b32 v17, v17, v21, s[78:79]
    v_cndmask_b32 v18, v18, v22, s[78:79]
    v_cndmask_b32 v19, v19, v23, s[78:79]
    ds_write_b32 v8, v16 offset:0
    ds_write_b32 v8, v17 offset:32
    ds_write_b32 v8, v18 offset:64
    ds_write_b32 v8, v19 offset:96
    s_mov_b64 exec, s[80:81]
    ds_write_b32 v9, v24 offset:512
    ds_write_b32 v9, v25 offset:544
    ds_write_b32 v9, v26 offset:576
    ds_write_b32 v9, v27 offset:608
    ds_write_b32 v9, v28 offset:768
    ds_write_b32 v9, v29 offset:800
    ds_write_b32 v9, v30 offset:832
    ds_write_b32 v9, v31 offset:864
    ds_write_b32 v9, v32 offset:1024
    ds_write_b32 v9, v33 offset:1056
    ds_write_b32 v9, v34 offset:1088
    ds_write_b32 v9, v35 offset:1120
    s_mov_b64 exec, -1
    s_waitcnt lgkmcnt(0)
    s_barrier
    s_add_u32 s4, s4, 1
    s_addc_u32 s5, s5, 0
    s_cmp_ge_u32 s34, 3
    s_cbranch_scc1 K1_PUB0_DONE
    v_cmp_gt_u32 vcc, 145, v0
    s_and_saveexec_b64 s[86:87], vcc
    v_lshlrev_b32 v8, 3, v0
    v_add_u32 v9, 64, v8
    v_cmp_gt_u32 vcc, 120, v0
    s_nop 1
    v_cndmask_b32 v8, v9, v8, vcc
    ds_read_b64 v[196:197], v8 offset:0
    ds_read_b64 v[198:199], v8 offset:1312
    ds_read_b64 v[200:201], v8 offset:2624
    ds_read_b64 v[202:203], v8 offset:3936
    ds_read_b64 v[204:205], v8 offset:5248
    ds_read_b64 v[206:207], v8 offset:6560
    ds_read_b64 v[208:209], v8 offset:7872
    ds_read_b64 v[210:211], v8 offset:9184
    ds_read_b64 v[212:213], v8 offset:10496
    ds_read_b64 v[214:215], v8 offset:11808
    ds_read_b64 v[216:217], v8 offset:13120
    ds_read_b64 v[218:219], v8 offset:14432
    ds_read_b64 v[220:221], v8 offset:15744
    ds_read_b64 v[222:223], v8 offset:17056
    ds_read_b64 v[224:225], v8 offset:18368
    ds_read_b64 v[226:227], v8 offset:19680
    s_waitcnt lgkmcnt(0)
    v_add_f32 v196, v196, v212
    v_add_f32 v197, v197, v213
    v_add_f32 v198, v198, v214
    v_add_f32 v199, v199, v215
    v_add_f32 v200, v200, v216
    v_add_f32 v201, v201, v217
    v_add_f32 v202, v202, v218
    v_add_f32 v203, v203, v219
    v_add_f32 v204, v204, v220
    v_add_f32 v205, v205, v221
    v_add_f32 v206, v206, v222
    v_add_f32 v207, v207, v223
    v_add_f32 v208, v208, v224
    v_add_f32 v209, v209, v225
    v_add_f32 v210, v210, v226
    v_add_f32 v211, v211, v227
    v_add_f32 v196, v196, v204
    v_add_f32 v197, v197, v205
    v_add_f32 v198, v198, v206
    v_add_f32 v199, v199, v207
    v_add_f32 v200, v200, v208
    v_add_f32 v201, v201, v209
    v_add_f32 v202, v202, v210
    v_add_f32 v203, v203, v211
    v_add_f32 v196, v196, v200
    v_add_f32 v197, v197, v201
    v_add_f32 v198, v198, v202
    v_add_f32 v199, v199, v203
    v_add_f32 v196, v196, v198
    v_add_f32 v197, v197, v199
    v_mov_b32 v198, s4
    v_mov_b32 v199, s5
    v_mov_b32 v200, s76
    v_cmp_eq_u32 vcc, 144, v0
    v_lshlrev_b32 v8, 4, v0
    s_nop 0
    v_cndmask_b32 v196, v196, v200, vcc
    s_mul_i32 s39, s85, 2560
    s_add_u32 s39, s39, 4096
    buffer_store_dwordx4 v[196:199], v8, s[72:75], s39 offen sc1
    s_mov_b64 exec, s[86:87]
    s_nop 1
K1_PUB0_DONE:
    buffer_load_dwordx4 v[72:75], v252, s[40:43], 0 offen offset:2560 nt
    buffer_load_dwordx4 v[76:79], v253, s[40:43], 0 offen offset:1536 nt
    buffer_load_dwordx4 v[80:83], v253, s[40:43], 0 offen offset:1664 nt
    buffer_load_dwordx4 v[84:87], v253, s[40:43], 0 offen offset:1792 nt
    buffer_load_dwordx4 v[88:91], v254, s[40:43], 0 offen offset:0 nt
    buffer_load_dwordx4 v[92:95], v254, s[40:43], 0 offen offset:128 nt
    buffer_load_dwordx4 v[96:99], v254, s[40:43], 0 offen offset:256 nt
    buffer_load_dwordx4 v[100:103], v255, s[40:43], 0 offen offset:768 nt
    buffer_load_dwordx4 v[104:107], v255, s[40:43], 0 offen offset:896 nt
    buffer_load_dwordx4 v[108:111], v255, s[40:43], 0 offen offset:1024 nt
    buffer_load_dwordx4 v[112:115], v254, s[40:43], 0 offen offset:2304 nt
    buffer_load_dwordx4 v[116:119], v254, s[40:43], 0 offen offset:2432 nt
    buffer_load_dwordx4 v[120:123], v254, s[40:43], 0 offen offset:2560 nt
    buffer_load_dwordx4 v[124:127], v255, s[40:43], 0 offen offset:1536 nt
    buffer_load_dwordx4 v[128:131], v255, s[40:43], 0 offen offset:1664 nt
    buffer_load_dwordx4 v[132:135], v255, s[40:43], 0 offen offset:1792 nt
    s_mul_i32 s39, s34, 288
    v_lshlrev_b32 v8, 4, v1
    v_add_u32 v8, s39, v8
    s_mul_i32 s88, s37, 20480
    s_add_u32 s88, s88, 4096
    v_and_b32 v15, 7, v1
    v_mul_u32_u24 v15, 2560, v15
    v_add_u32 v15, 2304, v15
    s_mov_b64 exec, 0x3ffff
    s_add_u32 s39, s88, 0
    buffer_load_dwordx4 v[196:199], v8, s[72:75], s39 offen sc1
    s_add_u32 s39, s88, 2560
    buffer_load_dwordx4 v[200:203], v8, s[72:75], s39 offen sc1
    s_add_u32 s39, s88, 5120
    buffer_load_dwordx4 v[204:207], v8, s[72:75], s39 offen sc1
    s_add_u32 s39, s88, 7680
    buffer_load_dwordx4 v[208:211], v8, s[72:75], s39 offen sc1
    s_add_u32 s39, s88, 10240
    buffer_load_dwordx4 v[212:215], v8, s[72:75], s39 offen sc1
    s_add_u32 s39, s88, 12800
    buffer_load_dwordx4 v[216:219], v8, s[72:75], s39 offen sc1
    s_add_u32 s39, s88, 15360
    buffer_load_dwordx4 v[220:223], v8, s[72:75], s39 offen sc1
    s_add_u32 s39, s88, 17920
    buffer_load_dwordx4 v[224:227], v8, s[72:75], s39 offen sc1
    buffer_load_dwordx4 v[228:231], v15, s[72:75], s88 offen sc1
    s_mov_b64 exec, -1
    v_mul_u32_u24 v38, 384, v2
    v_lshl_add_u32 v38, v3, 4, v38
    v_lshrrev_b32 v9, 3, v3
    v_lshl_add_u32 v9, v9, 2, v2
    v_mul_u32_u24 v39, 384, v9
    v_and_b32 v9, 7, v3
    v_lshl_add_u32 v39, v9, 4, v39
    v_add_u32 v39, 256, v39
    s_add_u32 s82, s84, 0
    s_and_b32 s82, s82, 7
    s_mul_i32 s82, s82, 3072
    buffer_load_dwordx4 v[136:139], v38, s[44:47], s82 offen offset:0 nt
    buffer_load_dwordx4 v[140:143], v38, s[44:47], s82 offen offset:1536 nt
    buffer_load_dwordx4 v[144:147], v39, s[44:47], s82 offen nt
    s_add_u32 s82, s84, 1
    s_and_b32 s82, s82, 7
    s_mul_i32 s82, s82, 3072
    buffer_load_dwordx4 v[148:151], v38, s[44:47], s82 offen offset:0 nt
    buffer_load_dwordx4 v[152:155], v38, s[44:47], s82 offen offset:1536 nt
    buffer_load_dwordx4 v[156:159], v39, s[44:47], s82 offen nt
    s_add_u32 s82, s84, 2
    s_and_b32 s82, s82, 7
    s_mul_i32 s82, s82, 3072
    buffer_load_dwordx4 v[160:163], v38, s[44:47], s82 offen offset:0 nt
    buffer_load_dwordx4 v[164:167], v38, s[44:47], s82 offen offset:1536 nt
    buffer_load_dwordx4 v[168:171], v39, s[44:47], s82 offen nt
    s_add_u32 s82, s84, 3
    s_and_b32 s82, s82, 7
    s_mul_i32 s82, s82, 3072
    buffer_load_dwordx4 v[172:175], v38, s[44:47], s82 offen offset:0 nt
    buffer_load_dwordx4 v[176:179], v38, s[44:47], s82 offen offset:1536 nt
    buffer_load_dwordx4 v[180:183], v39, s[44:47], s82 offen nt
    s_add_u32 s82, s84, 4
    s_and_b32 s82, s82, 7
    s_mul_i32 s82, s82, 3072
    buffer_load_dwordx4 v[184:187], v38, s[44:47], s82 offen offset:0 nt
    buffer_load_dwordx4 v[188:191], v38, s[44:47], s82 offen offset:1536 nt
    buffer_load_dwordx4 v[192:195], v39, s[44:47], s82 offen nt
    s_waitcnt vmcnt(15)
    s_mov_b64 exec, 0x3ffff
K1_GQ_CHECK:
    s_mov_b64 s[6:7], 0
    v_cmp_ne_u64 vcc, s[4:5], v[198:199]
    s_or_b64 s[6:7], s[6:7], vcc
    v_cmp_ne_u64 vcc, s[4:5], v[202:203]
    s_or_b64 s[6:7], s[6:7], vcc
    v_cmp_ne_u64 vcc, s[4:5], v[206:207]
    s_or_b64 s[6:7], s[6:7], vcc
    v_cmp_ne_u64 vcc, s[4:5], v[210:211]
    s_or_b64 s[6:7], s[6:7], vcc
    v_cmp_ne_u64 vcc, s[4:5], v[214:215]
    s_or_b64 s[6:7], s[6:7], vcc
    v_cmp_ne_u64 vcc, s[4:5], v[218:219]
    s_or_b64 s[6:7], s[6:7], vcc
    v_cmp_ne_u64 vcc, s[4:5], v[222:223]
    s_or_b64 s[6:7], s[6:7], vcc
    v_cmp_ne_u64 vcc, s[4:5], v[226:227]
    s_or_b64 s[6:7], s[6:7], vcc
    v_cmp_ne_u64 vcc, s[4:5], v[230:231]
    s_or_b64 s[6:7], s[6:7], vcc
    s_cmp_eq_u64 s[6:7], 0
    s_cbranch_scc1 K1_GQ_OK
    s_sub_u32 s3, s3, 1
    s_cbranch_scc1 K1_GQ_OK
    s_sleep 2
    s_add_u32 s39, s88, 0
    buffer_load_dwordx4 v[196:199], v8, s[72:75], s39 offen sc1
    s_add_u32 s39, s88, 2560
    buffer_load_dwordx4 v[200:203], v8, s[72:75], s39 offen sc1
    s_add_u32 s39, s88, 5120
    buffer_load_dwordx4 v[204:207], v8, s[72:75], s39 offen sc1
    s_add_u32 s39, s88, 7680
    buffer_load_dwordx4 v[208:211], v8, s[72:75], s39 offen sc1
    s_add_u32 s39, s88, 10240
    buffer_load_dwordx4 v[212:215], v8, s[72:75], s39 offen sc1
    s_add_u32 s39, s88, 12800
    buffer_load_dwordx4 v[216:219], v8, s[72:75], s39 offen sc1
    s_add_u32 s39, s88, 15360
    buffer_load_dwordx4 v[220:223], v8, s[72:75], s39 offen sc1
    s_add_u32 s39, s88, 17920
    buffer_load_dwordx4 v[224:227], v8, s[72:75], s39 offen sc1
    buffer_load_dwordx4 v[228:231], v15, s[72:75], s88 offen sc1
    s_waitcnt vmcnt(0)
    s_branch K1_GQ_CHECK
K1_GQ_OK:
    v_cmp_ne_u32 vcc, s76, v228
    s_cmp_eq_u64 vcc, 0
    s_cselect_b32 s77, -1, 0
    v_add_f32 v196, v196, v200
    v_add_f32 v197, v197, v201
    v_add_f32 v196, v196, v204
    v_add_f32 v197, v197, v205
    v_add_f32 v196, v196, v208
    v_add_f32 v197, v197, v209
    v_add_f32 v196, v196, v212
    v_add_f32 v197, v197, v213
    v_add_f32 v196, v196, v216
    v_add_f32 v197, v197, v217
    v_add_f32 v196, v196, v220
    v_add_f32 v197, v197, v221
    v_add_f32 v196, v196, v224
    v_add_f32 v197, v197, v225
    s_mul_i32 s39, s34, 18
    v_add_u32 v8, s39, v1
    v_cvt_pk_bf16_f32 v9, v196, v197
    v_lshlrev_b32 v10, 2, v8
    v_lshlrev_b32 v11, 3, v8
    v_cmp_gt_u32 vcc, 96, v8
    s_and_saveexec_b64 s[86:87], vcc
    ds_write_b32 v10, v9 offset:42496
    s_andn2_b64 exec, s[86:87], vcc
    ds_write_b64 v11, v[196:197] offset:42112
    s_mov_b64 exec, -1
    s_waitcnt lgkmcnt(0)
    s_barrier
    v_lshrrev_b32 v9, 3, v3
    v_lshlrev_b32 v9, 6, v9
    v_lshl_add_u32 v8, v2, 4, v9
    ds_read_b128 v[232:235], v8 offset:42496
    ds_read_b128 v[236:239], v8 offset:42624
    ds_read_b128 v[240:243], v8 offset:42752
    v_xor_b32 v10, 40, v1
    v_lshlrev_b32 v10, 2, v10
    s_waitcnt lgkmcnt(0)
    s_waitcnt vmcnt(45)
    v_mfma_f32_16x16x32_bf16 v[16:19], v[40:43], v[232:235], 0
    v_mfma_f32_16x16x32_bf16 v[16:19], v[44:47], v[236:239], v[16:19]
    v_mfma_f32_16x16x32_bf16 v[16:19], v[48:51], v[240:243], v[16:19]
    s_waitcnt vmcnt(42)
    v_mfma_f32_16x16x32_bf16 v[20:23], v[52:55], v[232:235], 0
    v_mfma_f32_16x16x32_bf16 v[20:23], v[56:59], v[236:239], v[20:23]
    v_mfma_f32_16x16x32_bf16 v[20:23], v[60:63], v[240:243], v[20:23]
    s_waitcnt vmcnt(39)
    v_mfma_f32_16x16x32_bf16 v[24:27], v[64:67], v[232:235], 0
    v_mfma_f32_16x16x32_bf16 v[24:27], v[68:71], v[236:239], v[24:27]
    v_mfma_f32_16x16x32_bf16 v[24:27], v[72:75], v[240:243], v[24:27]
    s_waitcnt vmcnt(36)
    v_mfma_f32_16x16x32_bf16 v[28:31], v[76:79], v[232:235], 0
    v_mfma_f32_16x16x32_bf16 v[28:31], v[80:83], v[236:239], v[28:31]
    v_mfma_f32_16x16x32_bf16 v[28:31], v[84:87], v[240:243], v[28:31]
    s_nop 7
    v_cndmask_b32 v12, v20, v16, s[80:81]
    v_cndmask_b32 v13, v28, v24, s[80:81]
    v_cndmask_b32 v244, v12, v13, s[78:79]
    v_cndmask_b32 v16, v13, v12, s[78:79]
    v_cndmask_b32 v12, v21, v17, s[80:81]
    v_cndmask_b32 v13, v29, v25, s[80:81]
    v_cndmask_b32 v245, v12, v13, s[78:79]
    v_cndmask_b32 v17, v13, v12, s[78:79]
    v_cndmask_b32 v12, v22, v18, s[80:81]
    v_cndmask_b32 v13, v30, v26, s[80:81]
    v_cndmask_b32 v246, v12, v13, s[78:79]
    v_cndmask_b32 v18, v13, v12, s[78:79]
    v_cndmask_b32 v12, v23, v19, s[80:81]
    v_cndmask_b32 v13, v31, v27, s[80:81]
    v_cndmask_b32 v247, v12, v13, s[78:79]
    v_cndmask_b32 v19, v13, v12, s[78:79]
    ds_bpermute_b32 v20, v10, v16
    ds_bpermute_b32 v21, v10, v17
    ds_bpermute_b32 v22, v10, v18
    ds_bpermute_b32 v23, v10, v19
    s_waitcnt lgkmcnt(0)
    v_add_f32 v244, v244, v20
    v_add_f32 v245, v245, v21
    v_add_f32 v246, v246, v22
    v_add_f32 v247, v247, v23
    s_waitcnt vmcnt(33)
    v_mfma_f32_16x16x32_bf16 v[16:19], v[88:91], v[232:235], 0
    v_mfma_f32_16x16x32_bf16 v[16:19], v[92:95], v[236:239], v[16:19]
    v_mfma_f32_16x16x32_bf16 v[16:19], v[96:99], v[240:243], v[16:19]
    s_waitcnt vmcnt(30)
    v_mfma_f32_16x16x32_bf16 v[20:23], v[100:103], v[232:235], 0
    v_mfma_f32_16x16x32_bf16 v[20:23], v[104:107], v[236:239], v[20:23]
    v_mfma_f32_16x16x32_bf16 v[20:23], v[108:111], v[240:243], v[20:23]
    s_waitcnt vmcnt(27)
    v_mfma_f32_16x16x32_bf16 v[24:27], v[112:115], v[232:235], 0
    v_mfma_f32_16x16x32_bf16 v[24:27], v[116:119], v[236:239], v[24:27]
    v_mfma_f32_16x16x32_bf16 v[24:27], v[120:123], v[240:243], v[24:27]
    s_waitcnt vmcnt(24)
    v_mfma_f32_16x16x32_bf16 v[28:31], v[124:127], v[232:235], 0
    v_mfma_f32_16x16x32_bf16 v[28:31], v[128:131], v[236:239], v[28:31]
    v_mfma_f32_16x16x32_bf16 v[28:31], v[132:135], v[240:243], v[28:31]
    s_nop 7
    v_cndmask_b32 v12, v20, v16, s[80:81]
    v_cndmask_b32 v13, v28, v24, s[80:81]
    v_cndmask_b32 v248, v12, v13, s[78:79]
    v_cndmask_b32 v16, v13, v12, s[78:79]
    v_cndmask_b32 v12, v21, v17, s[80:81]
    v_cndmask_b32 v13, v29, v25, s[80:81]
    v_cndmask_b32 v249, v12, v13, s[78:79]
    v_cndmask_b32 v17, v13, v12, s[78:79]
    v_cndmask_b32 v12, v22, v18, s[80:81]
    v_cndmask_b32 v13, v30, v26, s[80:81]
    v_cndmask_b32 v250, v12, v13, s[78:79]
    v_cndmask_b32 v18, v13, v12, s[78:79]
    v_cndmask_b32 v12, v23, v19, s[80:81]
    v_cndmask_b32 v13, v31, v27, s[80:81]
    v_cndmask_b32 v251, v12, v13, s[78:79]
    v_cndmask_b32 v19, v13, v12, s[78:79]
    ds_bpermute_b32 v20, v10, v16
    ds_bpermute_b32 v21, v10, v17
    ds_bpermute_b32 v22, v10, v18
    ds_bpermute_b32 v23, v10, v19
    s_waitcnt lgkmcnt(0)
    v_add_f32 v248, v248, v20
    v_add_f32 v249, v249, v21
    v_add_f32 v250, v250, v22
    v_add_f32 v251, v251, v23
    v_mov_b32 v16, v244
    v_mov_b32 v17, v245
    v_mov_b32 v18, v246
    v_mov_b32 v19, v247
    v_mov_b32 v20, v248
    v_mov_b32 v21, v249
    v_mov_b32 v22, v250
    v_mov_b32 v23, v251
    s_add_u32 s82, s84, 5
    s_and_b32 s82, s82, 7
    s_mul_i32 s82, s82, 3072
    buffer_load_dwordx4 v[196:199], v38, s[44:47], s82 offen offset:0 nt
    buffer_load_dwordx4 v[200:203], v38, s[44:47], s82 offen offset:1536 nt
    buffer_load_dwordx4 v[204:207], v39, s[44:47], s82 offen nt
    s_add_u32 s82, s84, 6
    s_and_b32 s82, s82, 7
    s_mul_i32 s82, s82, 3072
    buffer_load_dwordx4 v[208:211], v38, s[44:47], s82 offen offset:0 nt
    buffer_load_dwordx4 v[212:215], v38, s[44:47], s82 offen offset:1536 nt
    buffer_load_dwordx4 v[216:219], v39, s[44:47], s82 offen nt
    s_add_u32 s82, s84, 7
    s_and_b32 s82, s82, 7
    s_mul_i32 s82, s82, 3072
    buffer_load_dwordx4 v[220:223], v38, s[44:47], s82 offen offset:0 nt
    buffer_load_dwordx4 v[224:227], v38, s[44:47], s82 offen offset:1536 nt
    buffer_load_dwordx4 v[228:231], v39, s[44:47], s82 offen nt
    v_mul_u32_u24 v8, 1280, v2
    v_lshl_add_u32 v8, v3, 4, v8
    v_mov_b32 v9, 0x40000000
    v_cmp_gt_u32 vcc, 10, v3
    s_nop 1
    v_cndmask_b32 v8, v9, v8, vcc
    s_mul_i32 s82, s34, 10240
    s_add_u32 s39, s82, 0
    buffer_load_dwordx4 v[40:43], v8, s[52:55], s39 offen
    s_add_u32 s39, s82, 5120
    buffer_load_dwordx4 v[44:47], v8, s[52:55], s39 offen
    s_add_u32 s39, s82, 81920
    buffer_load_dwordx4 v[48:51], v8, s[52:55], s39 offen
    s_add_u32 s39, s82, 87040
    buffer_load_dwordx4 v[52:55], v8, s[52:55], s39 offen
    s_add_u32 s39, s82, 163840
    buffer_load_dwordx4 v[56:59], v8, s[52:55], s39 offen
    s_add_u32 s39, s82, 168960
    buffer_load_dwordx4 v[60:63], v8, s[52:55], s39 offen
    s_cmp_lt_u32 s34, 6
    s_cselect_b32 s39, 0, 0x40000000
    v_add_u32 v9, s39, v8
    v_or_b32 v9, v9, v8
    buffer_load_dwordx4 v[64:67], v9, s[64:67], s82 offen
    s_add_u32 s39, s82, 5120
    buffer_load_dwordx4 v[68:71], v9, s[64:67], s39 offen
    v_max3_f32 v9, v16, v17, v18
    v_max3_f32 v9, v9, v19, v20
    v_max3_f32 v9, v9, v21, v22
    v_max_f32 v9, v9, v23
    s_nop 1
    v_max_f32_dpp v9, v9, v9 row_ror:8 row_mask:0xf bank_mask:0xf
    s_nop 1
    v_readlane_b32 s88, v9, 0
    v_readlane_b32 s89, v9, 16
    v_readlane_b32 s90, v9, 32
    v_readlane_b32 s91, v9, 48
    s_nop 1
    v_mov_b32 v9, s88
    v_max_f32 v9, s89, v9
    v_max_f32 v9, s90, v9
    v_max_f32 v9, s91, v9
    s_lshl_b32 s39, s34, 2
    v_mov_b32 v10, s39
    ds_write_b32 v10, v9 offset:43776
    v_mul_f32 v9, s83, v9
    v_fma_f32 v16, v16, s83, -v9
    v_fma_f32 v17, v17, s83, -v9
    v_fma_f32 v18, v18, s83, -v9
    v_fma_f32 v19, v19, s83, -v9
    v_fma_f32 v20, v20, s83, -v9
    v_fma_f32 v21, v21, s83, -v9
    v_fma_f32 v22, v22, s83, -v9
    v_fma_f32 v23, v23, s83, -v9
    v_exp_f32 v16, v16
    v_exp_f32 v17, v17
    v_exp_f32 v18, v18
    v_exp_f32 v19, v19
    v_exp_f32 v20, v20
    v_exp_f32 v21, v21
    v_exp_f32 v22, v22
    v_exp_f32 v23, v23
    s_nop 0
    v_add_f32 v11, v16, v17
    v_add_f32 v11, v11, v18
    v_add_f32 v11, v11, v19
    v_add_f32 v11, v11, v20
    v_add_f32 v11, v11, v21
    v_add_f32 v11, v11, v22
    v_add_f32 v11, v11, v23
    s_nop 1
    v_add_f32_dpp v11, v11, v11 row_ror:8 row_mask:0xf bank_mask:0xf
    s_nop 1
    v_readlane_b32 s88, v11, 0
    v_readlane_b32 s89, v11, 16
    v_readlane_b32 s90, v11, 32
    v_readlane_b32 s91, v11, 48
    s_nop 1
    v_mov_b32 v11, s88
    v_add_f32 v11, s89, v11
    v_add_f32 v11, s90, v11
    v_add_f32 v11, s91, v11
    ds_write_b32 v10, v11 offset:43808
    v_cvt_pk_bf16_f32 v16, v16, v16
    v_cvt_pk_bf16_f32 v17, v17, v17
    v_cvt_pk_bf16_f32 v18, v18, v18
    v_cvt_pk_bf16_f32 v19, v19, v19
    v_cvt_pk_bf16_f32 v20, v20, v20
    v_cvt_pk_bf16_f32 v21, v21, v21
    v_cvt_pk_bf16_f32 v22, v22, v22
    v_cvt_pk_bf16_f32 v23, v23, v23
    s_waitcnt lgkmcnt(0)
    v_and_b32 v8, v16, v4
    v_and_b32 v9, v16, v5
    v_and_b32 v10, v16, v6
    v_and_b32 v11, v16, v7
    s_waitcnt vmcnt(29)
    s_nop 0
    v_mfma_f32_16x16x32_bf16 v[24:27], v[136:139], v[8:11], 0
    v_mfma_f32_16x16x32_bf16 v[28:31], v[140:143], v[8:11], 0
    v_mfma_f32_16x16x32_bf16 v[32:35], v[144:147], v[8:11], 0
    v_and_b32 v8, v17, v4
    v_and_b32 v9, v17, v5
    v_and_b32 v10, v17, v6
    v_and_b32 v11, v17, v7
    s_waitcnt vmcnt(26)
    s_nop 0
    v_mfma_f32_16x16x32_bf16 v[24:27], v[148:151], v[8:11], v[24:27]
    v_mfma_f32_16x16x32_bf16 v[28:31], v[152:155], v[8:11], v[28:31]
    v_mfma_f32_16x16x32_bf16 v[32:35], v[156:159], v[8:11], v[32:35]
    v_and_b32 v8, v18, v4
    v_and_b32 v9, v18, v5
    v_and_b32 v10, v18, v6
    v_and_b32 v11, v18, v7
    s_waitcnt vmcnt(23)
    s_nop 0
    v_mfma_f32_16x16x32_bf16 v[24:27], v[160:163], v[8:11], v[24:27]
    v_mfma_f32_16x16x32_bf16 v[28:31], v[164:167], v[8:11], v[28:31]
    v_mfma_f32_16x16x32_bf16 v[32:35], v[168:171], v[8:11], v[32:35]
    v_and_b32 v8, v19, v4
    v_and_b32 v9, v19, v5
    v_and_b32 v10, v19, v6
    v_and_b32 v11, v19, v7
    s_waitcnt vmcnt(20)
    s_nop 0
    v_mfma_f32_16x16x32_bf16 v[24:27], v[172:175], v[8:11], v[24:27]
    v_mfma_f32_16x16x32_bf16 v[28:31], v[176:179], v[8:11], v[28:31]
    v_mfma_f32_16x16x32_bf16 v[32:35], v[180:183], v[8:11], v[32:35]
    v_and_b32 v8, v20, v4
    v_and_b32 v9, v20, v5
    v_and_b32 v10, v20, v6
    v_and_b32 v11, v20, v7
    s_waitcnt vmcnt(17)
    s_nop 0
    v_mfma_f32_16x16x32_bf16 v[24:27], v[184:187], v[8:11], v[24:27]
    v_mfma_f32_16x16x32_bf16 v[28:31], v[188:191], v[8:11], v[28:31]
    v_mfma_f32_16x16x32_bf16 v[32:35], v[192:195], v[8:11], v[32:35]
    v_and_b32 v8, v21, v4
    v_and_b32 v9, v21, v5
    v_and_b32 v10, v21, v6
    v_and_b32 v11, v21, v7
    s_waitcnt vmcnt(14)
    s_nop 0
    v_mfma_f32_16x16x32_bf16 v[24:27], v[196:199], v[8:11], v[24:27]
    v_mfma_f32_16x16x32_bf16 v[28:31], v[200:203], v[8:11], v[28:31]
    v_mfma_f32_16x16x32_bf16 v[32:35], v[204:207], v[8:11], v[32:35]
    v_and_b32 v8, v22, v4
    v_and_b32 v9, v22, v5
    v_and_b32 v10, v22, v6
    v_and_b32 v11, v22, v7
    s_waitcnt vmcnt(11)
    s_nop 0
    v_mfma_f32_16x16x32_bf16 v[24:27], v[208:211], v[8:11], v[24:27]
    v_mfma_f32_16x16x32_bf16 v[28:31], v[212:215], v[8:11], v[28:31]
    v_mfma_f32_16x16x32_bf16 v[32:35], v[216:219], v[8:11], v[32:35]
    v_and_b32 v8, v23, v4
    v_and_b32 v9, v23, v5
    v_and_b32 v10, v23, v6
    v_and_b32 v11, v23, v7
    s_waitcnt vmcnt(8)
    s_nop 0
    v_mfma_f32_16x16x32_bf16 v[24:27], v[220:223], v[8:11], v[24:27]
    v_mfma_f32_16x16x32_bf16 v[28:31], v[224:227], v[8:11], v[28:31]
    v_mfma_f32_16x16x32_bf16 v[32:35], v[228:231], v[8:11], v[32:35]
    v_lshrrev_b32 v18, 3, v3
    s_lshl_b32 s39, s34, 1
    v_add_u32 v18, s39, v18
    v_mul_u32_u24 v16, 800, v18
    v_and_b32 v18, 7, v3
    v_lshl_add_u32 v16, v18, 2, v16
    v_and_b32 v18, 1, v2
    v_lshl_add_u32 v17, v18, 7, v16
    v_lshl_add_u32 v16, v2, 7, v16
    s_nop 7
    v_cndmask_b32 v24, v24, v28, s[78:79]
    v_cndmask_b32 v25, v25, v29, s[78:79]
    v_cndmask_b32 v26, v26, v30, s[78:79]
    v_cndmask_b32 v27, v27, v31, s[78:79]
    ds_write_b32 v16, v24 offset:20992
    ds_write_b32 v16, v25 offset:21024
    ds_write_b32 v16, v26 offset:21056
    ds_write_b32 v16, v27 offset:21088
    s_mov_b64 exec, s[80:81]
    ds_write_b32 v17, v32 offset:21504
    ds_write_b32 v17, v33 offset:21536
    ds_write_b32 v17, v34 offset:21568
    ds_write_b32 v17, v35 offset:21600
    s_mov_b64 exec, -1
    s_waitcnt lgkmcnt(0)
    s_barrier
    v_mov_b32 v137, 0
    ds_read_b32 v196, v137 offset:43840
    ds_read_b32 v197, v137 offset:43844
    ds_read_b32 v198, v137 offset:43848
    ds_read_b32 v199, v137 offset:43852
    ds_read_b32 v200, v137 offset:43856
    s_cmp_ge_u32 s34, 3
    s_cbranch_scc1 K1_T_WAIT
    s_cmp_eq_u32 s34, 2
    s_cbranch_scc1 K1_T_H
    v_lshlrev_b32 v136, 3, v0
    ds_read_b128 v[140:143], v137 offset:43776
    ds_read_b128 v[144:147], v137 offset:43792
    ds_read_b128 v[148:151], v137 offset:43808
    ds_read_b128 v[152:155], v137 offset:43824
    ds_read_b64 v[156:157], v136 offset:20992
    ds_read_b64 v[158:159], v136 offset:21792
    ds_read_b64 v[160:161], v136 offset:22592
    ds_read_b64 v[162:163], v136 offset:23392
    ds_read_b64 v[164:165], v136 offset:24192
    ds_read_b64 v[166:167], v136 offset:24992
    ds_read_b64 v[168:169], v136 offset:25792
    ds_read_b64 v[170:171], v136 offset:26592
    ds_read_b64 v[172:173], v136 offset:27392
    ds_read_b64 v[174:175], v136 offset:28192
    ds_read_b64 v[176:177], v136 offset:28992
    ds_read_b64 v[178:179], v136 offset:29792
    ds_read_b64 v[180:181], v136 offset:30592
    ds_read_b64 v[182:183], v136 offset:31392
    ds_read_b64 v[184:185], v136 offset:32192
    ds_read_b64 v[186:187], v136 offset:32992
    s_waitcnt lgkmcnt(0)
    v_max3_f32 v138, v140, v141, v142
    v_max3_f32 v138, v138, v143, v144
    v_max3_f32 v138, v138, v145, v146
    v_max_f32 v138, v138, v147
    v_sub_f32 v140, v140, v138
    v_sub_f32 v141, v141, v138
    v_sub_f32 v142, v142, v138
    v_sub_f32 v143, v143, v138
    v_sub_f32 v144, v144, v138
    v_sub_f32 v145, v145, v138
    v_sub_f32 v146, v146, v138
    v_sub_f32 v147, v147, v138
    v_mul_f32 v140, s83, v140
    v_mul_f32 v141, s83, v141
    v_mul_f32 v142, s83, v142
    v_mul_f32 v143, s83, v143
    v_mul_f32 v144, s83, v144
    v_mul_f32 v145, s83, v145
    v_mul_f32 v146, s83, v146
    v_mul_f32 v147, s83, v147
    v_exp_f32 v140, v140
    v_exp_f32 v141, v141
    v_exp_f32 v142, v142
    v_exp_f32 v143, v143
    v_exp_f32 v144, v144
    v_exp_f32 v145, v145
    v_exp_f32 v146, v146
    v_exp_f32 v147, v147
    s_nop 0
    v_mul_f32 v139, v140, v148
    v_fmac_f32 v139, v141, v149
    v_fmac_f32 v139, v142, v150
    v_fmac_f32 v139, v143, v151
    v_fmac_f32 v139, v144, v152
    v_fmac_f32 v139, v145, v153
    v_fmac_f32 v139, v146, v154
    v_fmac_f32 v139, v147, v155
    v_add_f32 v156, v156, v158
    v_add_f32 v157, v157, v159
    v_add_f32 v160, v160, v162
    v_add_f32 v161, v161, v163
    v_add_f32 v164, v164, v166
    v_add_f32 v165, v165, v167
    v_add_f32 v168, v168, v170
    v_add_f32 v169, v169, v171
    v_add_f32 v172, v172, v174
    v_add_f32 v173, v173, v175
    v_add_f32 v176, v176, v178
    v_add_f32 v177, v177, v179
    v_add_f32 v180, v180, v182
    v_add_f32 v181, v181, v183
    v_add_f32 v184, v184, v186
    v_add_f32 v185, v185, v187
    v_mul_f32 v188, v140, v156
    v_fmac_f32 v188, v141, v160
    v_fmac_f32 v188, v142, v164
    v_fmac_f32 v188, v143, v168
    v_fmac_f32 v188, v144, v172
    v_fmac_f32 v188, v145, v176
    v_fmac_f32 v188, v146, v180
    v_fmac_f32 v188, v147, v184
    v_mul_f32 v189, v140, v157
    v_fmac_f32 v189, v141, v161
    v_fmac_f32 v189, v142, v165
    v_fmac_f32 v189, v143, v169
    v_fmac_f32 v189, v144, v173
    v_fmac_f32 v189, v145, v177
    v_fmac_f32 v189, v146, v181
    v_fmac_f32 v189, v147, v185
    v_cmp_eq_u32 vcc, 96, v0
    v_lshlrev_b32 v192, 4, v0
    v_add_u32 v192, 16, v192
    v_cndmask_b32 v188, v188, v138, vcc
    v_cndmask_b32 v189, v189, v139, vcc
    v_cndmask_b32 v193, v192, 0, vcc
    v_mov_b32 v190, s4
    v_mov_b32 v191, s5
    s_lshl_b32 s39, s85, 11
    s_add_u32 s39, s39, 1048576
    v_cmp_gt_u32 vcc, 97, v0
    s_and_saveexec_b64 s[86:87], vcc
    s_add_u32 s82, s39, 524288
    buffer_store_dwordx4 v[188:191], v193, s[72:75], s82 offen
    buffer_store_dwordx4 v[188:191], v193, s[72:75], s39 offen sc1
    s_mov_b64 exec, s[86:87]
    v_add_f32 v196, v196, v197
    v_add_f32 v196, v196, v198
    v_add_f32 v196, v196, v199
    v_add_f32 v196, v196, v200
    v_mul_f32 v194, 0xbfb8aa3b, v196
    v_exp_f32 v194, v194
    s_nop 0
    v_add_f32 v194, 1.0, v194
    v_rcp_f32 v194, v194
    s_nop 0
    s_lshl_b32 s88, s37, 14
    s_add_u32 s88, s88, 1048576
    v_min_u32 v192, 1536, v192
    v_and_b32 v195, 7, v1
    v_lshlrev_b32 v195, 11, v195
K1_GO_LOOP:
    s_and_b32 s92, s3, 3
    s_cmp_eq_u32 s92, 0
    s_cselect_b32 s92, 0, 524288
    s_and_b32 s92, s92, s77
    s_add_u32 s92, s92, s88
    buffer_load_dwordx4 v[104:107], v195, s[72:75], s92 offen sc1
    buffer_load_dwordx4 v[72:75], v192, s[72:75], s92 offen offset:0 sc1
    buffer_load_dwordx4 v[76:79], v192, s[72:75], s92 offen offset:2048 sc1
    s_add_u32 s91, s92, 4096
    buffer_load_dwordx4 v[80:83], v192, s[72:75], s91 offen offset:0 sc1
    buffer_load_dwordx4 v[84:87], v192, s[72:75], s91 offen offset:2048 sc1
    s_add_u32 s91, s92, 8192
    buffer_load_dwordx4 v[88:91], v192, s[72:75], s91 offen offset:0 sc1
    buffer_load_dwordx4 v[92:95], v192, s[72:75], s91 offen offset:2048 sc1
    s_add_u32 s91, s92, 12288
    buffer_load_dwordx4 v[96:99], v192, s[72:75], s91 offen offset:0 sc1
    buffer_load_dwordx4 v[100:103], v192, s[72:75], s91 offen offset:2048 sc1
    s_waitcnt vmcnt(0)
    s_mov_b64 s[6:7], 0
    v_cmp_ne_u64 vcc, s[4:5], v[74:75]
    s_or_b64 s[6:7], s[6:7], vcc
    v_cmp_ne_u64 vcc, s[4:5], v[78:79]
    s_or_b64 s[6:7], s[6:7], vcc
    v_cmp_ne_u64 vcc, s[4:5], v[82:83]
    s_or_b64 s[6:7], s[6:7], vcc
    v_cmp_ne_u64 vcc, s[4:5], v[86:87]
    s_or_b64 s[6:7], s[6:7], vcc
    v_cmp_ne_u64 vcc, s[4:5], v[90:91]
    s_or_b64 s[6:7], s[6:7], vcc
    v_cmp_ne_u64 vcc, s[4:5], v[94:95]
    s_or_b64 s[6:7], s[6:7], vcc
    v_cmp_ne_u64 vcc, s[4:5], v[98:99]
    s_or_b64 s[6:7], s[6:7], vcc
    v_cmp_ne_u64 vcc, s[4:5], v[102:103]
    s_or_b64 s[6:7], s[6:7], vcc
    v_cmp_ne_u64 vcc, s[4:5], v[106:107]
    s_or_b64 s[6:7], s[6:7], vcc
    s_cmp_eq_u64 s[6:7], 0
    s_cbranch_scc1 K1_GO_OK
    s_sub_u32 s3, s3, 1
    s_cbranch_scc1 K1_GO_OK
    s_branch K1_GO_LOOP
K1_GO_OK:
    v_max_f32_dpp v138, v104, v104 quad_perm:[1,0,3,2] row_mask:0xf bank_mask:0xf
    s_nop 1
    v_max_f32_dpp v138, v138, v138 quad_perm:[2,3,0,1] row_mask:0xf bank_mask:0xf
    s_nop 1
    v_max_f32_dpp v138, v138, v138 row_half_mirror row_mask:0xf bank_mask:0xf
    s_nop 0
    v_sub_f32 v104, v104, v138
    v_mul_f32 v104, s83, v104
    v_exp_f32 v104, v104
    s_nop 0
    v_mul_f32 v139, v104, v105
    s_nop 1
    v_add_f32_dpp v139, v139, v139 quad_perm:[1,0,3,2] row_mask:0xf bank_mask:0xf
    s_nop 1
    v_add_f32_dpp v139, v139, v139 quad_perm:[2,3,0,1] row_mask:0xf bank_mask:0xf
    s_nop 1
    v_add_f32_dpp v139, v139, v139 row_half_mirror row_mask:0xf bank_mask:0xf
    v_readlane_b32 s40, v104, 0
    v_readlane_b32 s41, v104, 1
    v_readlane_b32 s42, v104, 2
    v_readlane_b32 s43, v104, 3
    v_readlane_b32 s44, v104, 4
    v_readlane_b32 s45, v104, 5
    v_readlane_b32 s46, v104, 6
    v_readlane_b32 s47, v104, 7
    v_rcp_f32 v139, v139
    v_mul_f32 v188, s40, v72
    v_fmac_f32 v188, s41, v76
    v_fmac_f32 v188, s42, v80
    v_fmac_f32 v188, s43, v84
    v_fmac_f32 v188, s44, v88
    v_fmac_f32 v188, s45, v92
    v_fmac_f32 v188, s46, v96
    v_fmac_f32 v188, s47, v100
    v_mul_f32 v189, s40, v73
    v_fmac_f32 v189, s41, v77
    v_fmac_f32 v189, s42, v81
    v_fmac_f32 v189, s43, v85
    v_fmac_f32 v189, s44, v89
    v_fmac_f32 v189, s45, v93
    v_fmac_f32 v189, s46, v97
    v_fmac_f32 v189, s47, v101
    v_mul_f32 v139, v139, v194
    v_mul_f32 v188, v188, v139
    v_mul_f32 v189, v189, v139
    v_cmp_gt_u32 vcc, 96, v0
    s_and_saveexec_b64 s[86:87], vcc
    v_cvt_pk_bf16_f32 v188, v188, v189
    v_lshlrev_b32 v136, 2, v0
    ds_write_b32 v136, v188 offset:43264
    s_mov_b64 exec, s[86:87]
    s_branch K1_T_WAIT
K1_T_H:
    v_lshlrev_b32 v136, 3, v1
    ds_read_b64 v[140:141], v136 offset:42880
    ds_read_b64 v[142:143], v136 offset:43072
    s_waitcnt lgkmcnt(0)
    v_add_f32 v196, v196, v197
    v_add_f32 v196, v196, v198
    v_add_f32 v196, v196, v199
    v_add_f32 v196, v196, v200
    v_mul_f32 v194, 0xbfb8aa3b, v196
    v_exp_f32 v194, v194
    s_nop 0
    v_add_f32 v194, 1.0, v194
    v_rcp_f32 v194, v194
    s_nop 0
    v_sub_f32 v194, 1.0, v194
    v_cvt_pk_bf16_f32 v140, v140, v141
    v_cvt_pk_bf16_f32 v142, v142, v143
    v_lshlrev_b32 v144, 16, v140
    v_and_b32 v145, 0xffff0000, v140
    v_lshlrev_b32 v146, 16, v142
    v_and_b32 v147, 0xffff0000, v142
    v_max_f32 v144, 0, v144
    v_max_f32 v145, 0, v145
    v_mul_f32 v144, v144, v146
    v_mul_f32 v145, v145, v147
    v_cvt_pk_bf16_f32 v144, v144, v145
    v_lshlrev_b32 v146, 16, v144
    v_and_b32 v147, 0xffff0000, v144
    v_mul_f32 v146, v146, v194
    v_mul_f32 v147, v147, v194
    v_cvt_pk_bf16_f32 v144, v146, v147
    v_cmp_gt_u32 vcc, 24, v1
    s_nop 1
    v_cndmask_b32 v144, 0, v144, vcc
    v_lshlrev_b32 v136, 2, v1
    s_mov_b64 exec, 0xffffffff
    ds_write_b32 v136, v144 offset:43648
    s_mov_b64 exec, -1
K1_T_WAIT:
    s_waitcnt lgkmcnt(0)
    s_barrier
    v_lshrrev_b32 v136, 3, v3
    v_lshl_add_u32 v136, v136, 2, v2
    v_lshlrev_b32 v136, 1, v136
    s_lshl_b32 s39, s34, 4
    v_add_u32 v136, s39, v136
    ds_read_u16 v156, v136 offset:43264
    ds_read_u16 v157, v136 offset:43392
    ds_read_u16 v158, v136 offset:43520
    ds_read_u16 v159, v136 offset:43648
    s_waitcnt lgkmcnt(0)
    v_lshl_or_b32 v156, v156, 16, v156
    v_lshl_or_b32 v157, v157, 16, v157
    v_lshl_or_b32 v158, v158, 16, v158
    v_lshl_or_b32 v159, v159, 16, v159
    v_and_b32 v140, v156, v4
    v_and_b32 v141, v156, v5
    v_and_b32 v142, v156, v6
    v_and_b32 v143, v156, v7
    v_and_b32 v144, v157, v4
    v_and_b32 v145, v157, v5
    v_and_b32 v146, v157, v6
    v_and_b32 v147, v157, v7
    v_and_b32 v148, v158, v4
    v_and_b32 v149, v158, v5
    v_and_b32 v150, v158, v6
    v_and_b32 v151, v158, v7
    v_and_b32 v152, v159, v4
    v_and_b32 v153, v159, v5
    v_and_b32 v154, v159, v6
    v_and_b32 v155, v159, v7
    s_waitcnt vmcnt(0)
    v_mfma_f32_16x16x32_bf16 v[160:163], v[40:43], v[140:143], 0
    v_mfma_f32_16x16x32_bf16 v[164:167], v[44:47], v[140:143], 0
    v_mfma_f32_16x16x32_bf16 v[160:163], v[48:51], v[144:147], v[160:163]
    v_mfma_f32_16x16x32_bf16 v[164:167], v[52:55], v[144:147], v[164:167]
    v_mfma_f32_16x16x32_bf16 v[160:163], v[56:59], v[148:151], v[160:163]
    v_mfma_f32_16x16x32_bf16 v[164:167], v[60:63], v[148:151], v[164:167]
    v_mfma_f32_16x16x32_bf16 v[160:163], v[64:67], v[152:155], v[160:163]
    v_mfma_f32_16x16x32_bf16 v[164:167], v[68:71], v[152:155], v[164:167]
    v_lshrrev_b32 v137, 3, v3
    s_lshl_b32 s39, s34, 1
    v_add_u32 v137, s39, v137
    v_mul_u32_u24 v136, 544, v137
    v_and_b32 v137, 7, v3
    v_lshl_add_u32 v136, v137, 2, v136
    v_lshl_add_u32 v136, v2, 7, v136
    s_nop 7
    v_cndmask_b32 v160, v160, v164, s[78:79]
    v_cndmask_b32 v161, v161, v165, s[78:79]
    v_cndmask_b32 v162, v162, v166, s[78:79]
    v_cndmask_b32 v163, v163, v167, s[78:79]
    ds_write_b32 v136, v160 offset:33792
    ds_write_b32 v136, v161 offset:33824
    ds_write_b32 v136, v162 offset:33856
    ds_write_b32 v136, v163 offset:33888
    s_waitcnt lgkmcnt(0)
    s_barrier
    s_cmp_lg_u32 s34, 0
    s_cbranch_scc1 K1_PUB3_DONE
    s_mov_b32 exec_lo, -1
    s_mov_b32 exec_hi, 0xff
    v_lshlrev_b32 v136, 3, v0
    ds_read_b64 v[140:141], v136 offset:33792
    ds_read_b64 v[142:143], v136 offset:34336
    ds_read_b64 v[144:145], v136 offset:34880
    ds_read_b64 v[146:147], v136 offset:35424
    ds_read_b64 v[148:149], v136 offset:35968
    ds_read_b64 v[150:151], v136 offset:36512
    ds_read_b64 v[152:153], v136 offset:37056
    ds_read_b64 v[154:155], v136 offset:37600
    ds_read_b64 v[156:157], v136 offset:38144
    ds_read_b64 v[158:159], v136 offset:38688
    ds_read_b64 v[160:161], v136 offset:39232
    ds_read_b64 v[162:163], v136 offset:39776
    ds_read_b64 v[164:165], v136 offset:40320
    ds_read_b64 v[166:167], v136 offset:40864
    ds_read_b64 v[168:169], v136 offset:41408
    ds_read_b64 v[170:171], v136 offset:41952
    s_waitcnt lgkmcnt(0)
    v_add_f32 v140, v140, v156
    v_add_f32 v141, v141, v157
    v_add_f32 v142, v142, v158
    v_add_f32 v143, v143, v159
    v_add_f32 v144, v144, v160
    v_add_f32 v145, v145, v161
    v_add_f32 v146, v146, v162
    v_add_f32 v147, v147, v163
    v_add_f32 v148, v148, v164
    v_add_f32 v149, v149, v165
    v_add_f32 v150, v150, v166
    v_add_f32 v151, v151, v167
    v_add_f32 v152, v152, v168
    v_add_f32 v153, v153, v169
    v_add_f32 v154, v154, v170
    v_add_f32 v155, v155, v171
    v_add_f32 v140, v140, v148
    v_add_f32 v141, v141, v149
    v_add_f32 v142, v142, v150
    v_add_f32 v143, v143, v151
    v_add_f32 v144, v144, v152
    v_add_f32 v145, v145, v153
    v_add_f32 v146, v146, v154
    v_add_f32 v147, v147, v155
    v_add_f32 v140, v140, v144
    v_add_f32 v141, v141, v145
    v_add_f32 v142, v142, v146
    v_add_f32 v143, v143, v147
    v_add_f32 v140, v140, v142
    v_add_f32 v141, v141, v143
    v_mov_b32 v142, s4
    v_mov_b32 v143, s5
    v_lshlrev_b32 v136, 4, v0
    s_lshl_b32 s39, s38, 5
    s_add_u32 s39, s39, s37
    s_mul_i32 s39, s39, 640
    s_add_u32 s39, s39, 2097152
    buffer_store_dwordx4 v[140:143], v136, s[72:75], s39 offen sc1
    s_mov_b64 exec, -1
K1_PUB3_DONE:
    s_lshl_b32 s39, s38, 2
    s_cmp_lg_u32 s39, s37
    s_cbranch_scc1 K1_STAMPS
    s_lshl_b32 s88, s38, 5
    s_lshl_b32 s39, s34, 2
    s_add_u32 s88, s88, s39
    s_mul_i32 s88, s88, 640
    s_add_u32 s88, s88, 2097152
    v_lshlrev_b32 v136, 4, v1
    s_mov_b32 exec_lo, -1
    s_mov_b32 exec_hi, 0xff
K1_GF_LOOP:
    buffer_load_dwordx4 v[140:143], v136, s[72:75], s88 offen offset:0 sc1
    buffer_load_dwordx4 v[144:147], v136, s[72:75], s88 offen offset:640 sc1
    buffer_load_dwordx4 v[148:151], v136, s[72:75], s88 offen offset:1280 sc1
    buffer_load_dwordx4 v[152:155], v136, s[72:75], s88 offen offset:1920 sc1
    s_waitcnt vmcnt(0)
    s_mov_b64 s[6:7], 0
    v_cmp_ne_u64 vcc, s[4:5], v[142:143]
    s_or_b64 s[6:7], s[6:7], vcc
    v_cmp_ne_u64 vcc, s[4:5], v[146:147]
    s_or_b64 s[6:7], s[6:7], vcc
    v_cmp_ne_u64 vcc, s[4:5], v[150:151]
    s_or_b64 s[6:7], s[6:7], vcc
    v_cmp_ne_u64 vcc, s[4:5], v[154:155]
    s_or_b64 s[6:7], s[6:7], vcc
    s_cmp_eq_u64 s[6:7], 0
    s_cbranch_scc1 K1_GF_OK
    s_sub_u32 s3, s3, 1
    s_cbranch_scc1 K1_GF_OK
    s_sleep 1
    s_branch K1_GF_LOOP
K1_GF_OK:
    v_add_f32 v140, v140, v144
    v_add_f32 v141, v141, v145
    v_add_f32 v140, v140, v148
    v_add_f32 v141, v141, v149
    v_add_f32 v140, v140, v152
    v_add_f32 v141, v141, v153
    v_lshlrev_b32 v136, 3, v1
    s_mul_i32 s39, s34, 320
    v_add_u32 v136, s39, v136
    ds_write_b64 v136, v[140:141] offset:43904
    s_mov_b64 exec, -1
    s_waitcnt lgkmcnt(0)
    s_barrier
    s_cmp_lg_u32 s34, 0
    s_cbranch_scc1 K1_STAMPS
    s_mov_b32 exec_lo, -1
    s_mov_b32 exec_hi, 0xff
    v_lshlrev_b32 v136, 3, v1
    ds_read_b64 v[140:141], v136 offset:43904
    ds_read_b64 v[142:143], v136 offset:44224
    ds_read_b64 v[144:145], v136 offset:44544
    ds_read_b64 v[146:147], v136 offset:44864
    ds_read_b64 v[148:149], v136 offset:45184
    ds_read_b64 v[150:151], v136 offset:45504
    ds_read_b64 v[152:153], v136 offset:45824
    ds_read_b64 v[154:155], v136 offset:46144
    s_mov_b32 s56, s28
    s_and_b32 s57, s29, 0xffff
    s_mov_b32 s58, 1280
    s_mov_b32 s59, 0x00020000
    s_waitcnt lgkmcnt(0)
    v_add_f32 v140, v140, v148
    v_add_f32 v141, v141, v149
    v_add_f32 v142, v142, v150
    v_add_f32 v143, v143, v151
    v_add_f32 v144, v144, v152
    v_add_f32 v145, v145, v153
    v_add_f32 v146, v146, v154
    v_add_f32 v147, v147, v155
    v_add_f32 v140, v140, v144
    v_add_f32 v141, v141, v145
    v_add_f32 v142, v142, v146
    v_add_f32 v143, v143, v147
    v_add_f32 v140, v140, v142
    v_add_f32 v141, v141, v143
    v_cvt_pk_bf16_f32 v140, v140, v141
    v_lshlrev_b32 v136, 2, v1
    s_mul_i32 s39, s38, 160
    buffer_store_dword v140, v136, s[56:59], s39 offen
    s_cmp_lg_u32 s38, 0
    s_cbranch_scc1 K1_NOEP
    s_mov_b64 exec, 1
    v_mov_b32 v142, s4
    v_mov_b32 v143, s5
    v_mov_b32 v136, 0
    buffer_store_dwordx2 v[142:143], v136, s[72:75], 0 offen
K1_NOEP:
    s_mov_b64 exec, -1
K1_STAMPS:
K1_END:
    s_endpgm
.section .rodata,"a"
.p2align 6
.amdhsa_kernel gated_mix__sliding_block_cached__glu_gated_reglu__decode_kernel
  .amdhsa_next_free_vgpr 256
  .amdhsa_next_free_sgpr 102
  .amdhsa_accum_offset 256
  .amdhsa_group_segment_fixed_size 0
  .amdhsa_kernarg_size 104
  .amdhsa_user_sgpr_count 2
  .amdhsa_user_sgpr_kernarg_segment_ptr 1
  .amdhsa_system_sgpr_workgroup_id_x 1
.end_amdhsa_kernel
```
